```python
import torch

def _softmax(x, axis=-1):
    return torch.softmax(x, dim=axis)
def _gelu(x):
    return torch.nn.functional.gelu(x, approximate="tanh")
def _silu(x):
    return torch.nn.functional.silu(x)
def _sigmoid(x):
    return torch.sigmoid(x)
def _layernorm(x, axis=-1, eps=1e-5):
    m = x.mean(dim=axis, keepdim=True)
    v = x.var(dim=axis, keepdim=True, unbiased=False)
    return (x - m) / torch.sqrt(v + eps)
def _scatter_add(tgt, idx, src, axis=0):
    return tgt.clone().index_add_(axis, idx, src)
def _segment_sum(src, seg, n):
    out = torch.zeros((n,) + src.shape[1:], dtype=src.dtype)
    return out.index_add_(0, seg, src)
def _pad(x, pw):
    flat = tuple(v for pair in reversed(pw) for v in pair)
    return torch.nn.functional.pad(x, flat)

kernel_name = 'standalone__paged_block_table_kv_pagedattention__decode'

def setup_inputs():

    _w = (lambda a: (lambda t: t.to(torch.bfloat16) if t.is_floating_point() else t)(torch.as_tensor(a)))
    B, Hq, Hkv, Sq, Skv, D = 2, 32, 32, 1, 8192, 128
    bs = 16
    nbps = max(1, Skv // bs)
    num_phys = B * nbps + 4
    bt = torch.randperm(num_phys)[: B * nbps].reshape(B, nbps).to(torch.int64)
    cl = (nbps * bs - (torch.arange(1, B + 1, dtype=torch.int64) * 2654435761) % max(1, nbps * bs // 2)).to(torch.int64)
    return {
        "q": _w((lambda *s: torch.randn(*s, dtype=torch.bfloat16) * 0.8)(B, Hq, Sq, D)),
        "k_cache": _w((lambda *s: torch.randn(*s, dtype=torch.bfloat16) * 0.8)(num_phys, bs, Hkv, D)),
        "v_cache": _w((lambda *s: torch.randn(*s, dtype=torch.bfloat16) * 0.05)(num_phys, bs, Hkv, D)),
        "block_table": _w(bt),
        "context_lens": _w(cl),
    }

def reference(q, k_cache, v_cache, block_table, context_lens):
    B, Hq, Sq, D = q.shape
    bs = k_cache.shape[1]
    Hkv = k_cache.shape[2]
    nbps = block_table.shape[1]
    Skv = nbps * bs
    bt = block_table.reshape(-1)
    k = (lambda x, *d: x.permute(*d))(k_cache[bt].reshape(B, Skv, Hkv, D), 0, 2, 1, 3)
    v = (lambda x, *d: x.permute(*d))(v_cache[bt].reshape(B, Skv, Hkv, D), 0, 2, 1, 3)
    g = Hq // Hkv
    qg = q.reshape(B, Hkv, g, Sq, D)
    scores = torch.einsum("bhgqd,bhkd->bhgqk", qg, k) * (D ** -0.5)
    pos = torch.arange(Skv)
    msk = pos[None, :] < context_lens[:, None]
    scores = torch.where(msk[:, None, None, None, :], scores, -1e9)
    p = _softmax(scores, axis=-1)
    out = torch.einsum("bhgqk,bhkd->bhgqd", p, v)
    return out.reshape(B, Hq, Sq, D)
```

```asm
; @launch kernel=pa_main_kernel grid=(256,1,1) block=(1024,1,1) lds=33280
; @launch kernel=pa_merge_kernel grid=(64,1,1) block=(512,1,1) lds=8320
.amdgcn_target "amdgcn-amd-amdhsa--gfx950"
.text
.globl pa_main_kernel
.globl pa_merge_kernel
.type pa_main_kernel,@function
.type pa_merge_kernel,@function
.p2align 8
pa_main_kernel:
    s_cmp_ge_u32 s2, 256
    s_cbranch_scc1 L_main_end

    s_load_dwordx4 s[4:7], s[0:1], 0
    s_load_dwordx4 s[8:11], s[0:1], 16
    s_load_dwordx4 s[12:15], s[0:1], 32
    s_load_dwordx4 s[16:19], s[0:1], 48
    v_lshrrev_b32 v3, 6, v0
    v_and_b32 v1, 63, v0
    v_readfirstlane_b32 s56, v3
    v_lshlrev_b32 v2, 2, v1
    v_lshlrev_b32 v1, 4, v1
    s_waitcnt lgkmcnt(0)
    s_load_dwordx2 s[40:41], s[12:13], 0
    s_mov_b32 s20, s6
    s_and_b32 s21, s7, 0xffff
    s_mov_b32 s22, 0x8080000
    s_mov_b32 s23, 0x00020000
    s_mov_b32 s24, s8
    s_and_b32 s25, s9, 0xffff
    s_mov_b32 s26, 0x8080000
    s_mov_b32 s27, 0x00020000
    s_mov_b32 s28, s4
    s_and_b32 s29, s5, 0xffff
    s_mov_b32 s30, 16384
    s_mov_b32 s31, 0x00020000
    s_mov_b32 s32, s10
    s_and_b32 s33, s11, 0xffff
    s_mov_b32 s34, 4096
    s_mov_b32 s35, 0x00020000
    s_mov_b32 s36, s18
    s_and_b32 s37, s19, 0xffff
    s_mov_b32 s38, 0x1000000
    s_mov_b32 s39, 0x00020000
    s_mov_b32 s60, 0x3e0293ee
    s_lshr_b32 s47, s2, 2
    s_and_b32 s48, s2, 3
    s_and_b32 s58, s56, 1
    s_lshr_b32 s57, s56, 1
    s_lshl_b32 s82, s48, 1
    s_add_u32 s58, s58, s82
    s_waitcnt lgkmcnt(0)

    s_cmp_lt_i32 s40, 1
    s_cselect_b32 s42, 8192, s40
    s_min_u32 s42, s42, 8192
    s_cmp_lt_i32 s41, 1
    s_cselect_b32 s43, 8192, s41
    s_min_u32 s43, s43, 8192
    s_add_u32 s44, s42, 3
    s_lshr_b32 s44, s44, 2
    s_add_u32 s45, s43, 3
    s_lshr_b32 s45, s45, 2
    s_add_u32 s82, s44, s45
    v_cvt_f32_u32 v3, s44
    v_cvt_f32_u32 v4, s82
    v_rcp_f32 v4, v4
    s_nop 0
    v_mul_f32 v3, v3, v4
    v_mul_f32 v3, 0x42800000, v3
    v_add_f32 v3, 0.5, v3
    v_cvt_u32_f32 v3, v3
    s_nop 0
    v_readfirstlane_b32 s46, v3
    s_nop 3
    s_max_u32 s46, s46, 1
    s_min_u32 s46, s46, 63

    s_cmp_ge_u32 s47, s46
    s_cselect_b32 s49, 1, 0
    s_cselect_b32 s82, s46, 0
    s_cselect_b32 s52, s45, s44
    s_cselect_b32 s53, s43, s42
    s_cselect_b32 s83, s41, s40
    s_sub_u32 s50, s47, s82
    s_sub_u32 s84, 64, s46
    s_cmp_ge_u32 s47, s46
    s_cselect_b32 s51, s84, s46
    s_cmp_lt_i32 s83, 1
    s_cselect_b32 s30, 0, 16384
    v_cvt_f32_u32 v3, s52
    v_cvt_f32_u32 v4, s51
    v_rcp_f32 v4, v4
    s_add_u32 s84, s50, 1
    v_cvt_f32_u32 v5, s50
    v_cvt_f32_u32 v6, s84
    v_mul_f32 v3, v3, v4
    v_mul_f32 v5, v5, v3
    v_mul_f32 v6, v6, v3
    v_cvt_u32_f32 v5, v5
    v_cvt_u32_f32 v6, v6
    s_nop 0
    v_readfirstlane_b32 s54, v5
    v_readfirstlane_b32 s55, v6
    s_nop 3
    s_min_u32 s54, s54, s52
    s_min_u32 s55, s55, s52
    s_cmp_eq_u32 s84, s51
    s_cselect_b32 s55, s52, s55
    s_lshr_b32 s59, s54, 2
    s_lshl_b32 s82, s49, 9
    s_add_u32 s82, s82, s59
    s_lshl_b32 s82, s82, 2
    buffer_load_dword v2, v2, s[32:35], s82 offen
    s_lshl_b32 s82, s49, 13
    s_lshl_b32 s83, s58, 10
    s_add_u32 s82, s82, s83
    buffer_load_dwordx4 v[4:7], v1, s[28:31], s82 offen
    s_lshl_b32 s61, s55, 2
    s_min_u32 s61, s61, s53

    s_add_u32 s64, s54, s57
    s_mov_b32 s63, s64
    s_sub_u32 s62, s55, s54
    s_sub_u32 s62, s62, s57
    s_add_i32 s62, s62, 15
    s_max_i32 s62, s62, 0
    s_lshr_b32 s62, s62, 4

    s_lshl_b32 s65, s58, 10
    v_mov_b32 v8, 0
    v_mov_b32 v9, 0
    v_mov_b32 v10, 0
    v_mov_b32 v11, 0
    v_mov_b32 v12, 0
    v_mov_b32 v13, 0
    v_mov_b32 v14, 0
    v_mov_b32 v15, 0
    v_mov_b32 v16, 0xf1800000
    v_mov_b32 v17, 0
    s_waitcnt vmcnt(1)

    s_lshr_b32 s82, s63, 2
    s_sub_u32 s82, s82, s59
    s_and_b32 s82, s82, 63
    v_readlane_b32 s83, v2, s82
    s_and_b32 s84, s63, 3
    s_lshl_b32 s84, s84, 15
    s_add_u32 s84, s84, s65
    s_lshl_b32 s83, s83, 17
    s_add_u32 s83, s83, s84
    s_cmp_lt_u32 s63, s55
    s_cselect_b32 s66, s83, 0x8080000
    s_cselect_b32 s84, 8192, 0

    s_add_u32 s67, s66, s84
    s_add_u32 s68, s67, s84
    s_add_u32 s69, s68, s84
    buffer_load_dwordx4 v[36:39], v1, s[20:23], s66 offen nt
    buffer_load_dwordx4 v[40:43], v1, s[20:23], s67 offen nt
    buffer_load_dwordx4 v[44:47], v1, s[20:23], s68 offen nt
    buffer_load_dwordx4 v[48:51], v1, s[20:23], s69 offen nt
    buffer_load_dwordx4 v[68:71], v1, s[24:27], s66 offen nt
    buffer_load_dwordx4 v[72:75], v1, s[24:27], s67 offen nt
    buffer_load_dwordx4 v[76:79], v1, s[24:27], s68 offen nt
    buffer_load_dwordx4 v[80:83], v1, s[24:27], s69 offen nt
    s_add_u32 s63, s63, 8
    s_lshr_b32 s82, s63, 2
    s_sub_u32 s82, s82, s59
    s_and_b32 s82, s82, 63
    v_readlane_b32 s83, v2, s82
    s_and_b32 s84, s63, 3
    s_lshl_b32 s84, s84, 15
    s_add_u32 s84, s84, s65
    s_lshl_b32 s83, s83, 17
    s_add_u32 s83, s83, s84
    s_cmp_lt_u32 s63, s55
    s_cselect_b32 s74, s83, 0x8080000
    s_cselect_b32 s84, 8192, 0

    s_add_u32 s75, s74, s84
    s_add_u32 s76, s75, s84
    s_add_u32 s77, s76, s84
    buffer_load_dwordx4 v[52:55], v1, s[20:23], s74 offen nt
    buffer_load_dwordx4 v[56:59], v1, s[20:23], s75 offen nt
    buffer_load_dwordx4 v[60:63], v1, s[20:23], s76 offen nt
    buffer_load_dwordx4 v[64:67], v1, s[20:23], s77 offen nt
    buffer_load_dwordx4 v[84:87], v1, s[24:27], s74 offen nt
    buffer_load_dwordx4 v[88:91], v1, s[24:27], s75 offen nt
    buffer_load_dwordx4 v[92:95], v1, s[24:27], s76 offen nt
    buffer_load_dwordx4 v[96:99], v1, s[24:27], s77 offen nt
    s_add_u32 s63, s63, 8

    s_cmp_eq_u32 s62, 0
    s_cbranch_scc1 L_loop_done

L_loop:
    s_waitcnt vmcnt(12)
    v_dot2_f32_bf16 v20, v36, v4, 0
    v_dot2_f32_bf16 v21, v40, v4, 0
    v_dot2_f32_bf16 v22, v44, v4, 0
    v_dot2_f32_bf16 v23, v48, v4, 0
    v_dot2_f32_bf16 v20, v37, v5, v20
    v_dot2_f32_bf16 v21, v41, v5, v21
    v_dot2_f32_bf16 v22, v45, v5, v22
    v_dot2_f32_bf16 v23, v49, v5, v23
    v_dot2_f32_bf16 v20, v38, v6, v20
    v_dot2_f32_bf16 v21, v42, v6, v21
    v_dot2_f32_bf16 v22, v46, v6, v22
    v_dot2_f32_bf16 v23, v50, v6, v23
    v_dot2_f32_bf16 v20, v39, v7, v20
    v_dot2_f32_bf16 v21, v43, v7, v21
    v_dot2_f32_bf16 v22, v47, v7, v22
    v_dot2_f32_bf16 v23, v51, v7, v23
    s_lshr_b32 s82, s63, 2
    s_sub_u32 s82, s82, s59
    s_and_b32 s82, s82, 63
    v_readlane_b32 s83, v2, s82
    s_and_b32 s84, s63, 3
    s_lshl_b32 s84, s84, 15
    s_add_u32 s84, s84, s65
    s_lshl_b32 s83, s83, 17
    s_add_u32 s83, s83, s84
    s_cmp_lt_u32 s63, s55
    s_cselect_b32 s66, s83, 0x8080000
    s_cselect_b32 s84, 8192, 0

    s_add_u32 s67, s66, s84
    s_add_u32 s68, s67, s84
    s_add_u32 s69, s68, s84
    buffer_load_dwordx4 v[36:39], v1, s[20:23], s66 offen nt
    buffer_load_dwordx4 v[40:43], v1, s[20:23], s67 offen nt
    buffer_load_dwordx4 v[44:47], v1, s[20:23], s68 offen nt
    buffer_load_dwordx4 v[48:51], v1, s[20:23], s69 offen nt
    v_add_f32_dpp v20, v20, v20 row_ror:8 row_mask:0xf bank_mask:0xf
    v_add_f32_dpp v21, v21, v21 row_ror:8 row_mask:0xf bank_mask:0xf
    v_add_f32_dpp v22, v22, v22 row_ror:8 row_mask:0xf bank_mask:0xf
    v_add_f32_dpp v23, v23, v23 row_ror:8 row_mask:0xf bank_mask:0xf
    v_add_f32_dpp v20, v20, v20 row_ror:4 row_mask:0xf bank_mask:0xf
    v_add_f32_dpp v21, v21, v21 row_ror:4 row_mask:0xf bank_mask:0xf
    v_add_f32_dpp v22, v22, v22 row_ror:4 row_mask:0xf bank_mask:0xf
    v_add_f32_dpp v23, v23, v23 row_ror:4 row_mask:0xf bank_mask:0xf
    v_add_f32_dpp v20, v20, v20 row_ror:2 row_mask:0xf bank_mask:0xf
    v_add_f32_dpp v21, v21, v21 row_ror:2 row_mask:0xf bank_mask:0xf
    v_add_f32_dpp v22, v22, v22 row_ror:2 row_mask:0xf bank_mask:0xf
    v_add_f32_dpp v23, v23, v23 row_ror:2 row_mask:0xf bank_mask:0xf
    v_add_f32_dpp v20, v20, v20 row_ror:1 row_mask:0xf bank_mask:0xf
    v_add_f32_dpp v21, v21, v21 row_ror:1 row_mask:0xf bank_mask:0xf
    v_add_f32_dpp v22, v22, v22 row_ror:1 row_mask:0xf bank_mask:0xf
    v_add_f32_dpp v23, v23, v23 row_ror:1 row_mask:0xf bank_mask:0xf
    s_lshl_b32 s82, s64, 2
    s_sub_i32 s82, s61, s82

    s_cmp_gt_i32 s82, 3
    s_cbranch_scc1 L_nomask_1
    v_mov_b32 v23, 0xff800000

    s_cmp_gt_i32 s82, 2
    s_cbranch_scc1 L_nomask_1
    v_mov_b32 v22, 0xff800000

    s_cmp_gt_i32 s82, 1
    s_cbranch_scc1 L_nomask_1
    v_mov_b32 v21, 0xff800000

    s_cmp_gt_i32 s82, 0
    s_cbranch_scc1 L_nomask_1
    v_mov_b32 v20, 0xff800000

L_nomask_1:
    v_max3_f32 v18, v20, v21, v16
    v_max3_f32 v18, v22, v23, v18
    v_mul_f32 v3, s60, v18
    v_fma_f32 v19, v16, s60, -v3

    v_fma_f32 v20, v20, s60, -v3
    v_fma_f32 v21, v21, s60, -v3
    v_fma_f32 v22, v22, s60, -v3
    v_fma_f32 v23, v23, s60, -v3
    v_exp_f32 v19, v19
    v_exp_f32 v20, v20
    v_exp_f32 v21, v21
    v_exp_f32 v22, v22
    v_exp_f32 v23, v23
    v_mov_b32 v16, v18
    v_mul_f32 v8, v19, v8
    v_mul_f32 v9, v19, v9
    v_mul_f32 v10, v19, v10
    v_mul_f32 v11, v19, v11
    v_mul_f32 v12, v19, v12
    v_mul_f32 v13, v19, v13
    v_mul_f32 v14, v19, v14
    v_mul_f32 v15, v19, v15
    v_mul_f32 v17, v19, v17
    v_add_f32 v17, v17, v20
    v_add_f32 v17, v17, v21
    v_add_f32 v17, v17, v22
    v_add_f32 v17, v17, v23
    s_waitcnt vmcnt(12)
    v_lshlrev_b32 v28, 16, v68
    v_and_b32 v29, 0xffff0000, v68
    v_lshlrev_b32 v30, 16, v69
    v_and_b32 v31, 0xffff0000, v69
    v_lshlrev_b32 v32, 16, v70
    v_and_b32 v33, 0xffff0000, v70
    v_lshlrev_b32 v34, 16, v71
    v_and_b32 v35, 0xffff0000, v71
    v_fmac_f32 v8, v20, v28
    v_fmac_f32 v9, v20, v29
    v_fmac_f32 v10, v20, v30
    v_fmac_f32 v11, v20, v31
    v_fmac_f32 v12, v20, v32
    v_fmac_f32 v13, v20, v33
    v_fmac_f32 v14, v20, v34
    v_fmac_f32 v15, v20, v35
    v_lshlrev_b32 v28, 16, v72
    v_and_b32 v29, 0xffff0000, v72
    v_lshlrev_b32 v30, 16, v73
    v_and_b32 v31, 0xffff0000, v73
    v_lshlrev_b32 v32, 16, v74
    v_and_b32 v33, 0xffff0000, v74
    v_lshlrev_b32 v34, 16, v75
    v_and_b32 v35, 0xffff0000, v75
    v_fmac_f32 v8, v21, v28
    v_fmac_f32 v9, v21, v29
    v_fmac_f32 v10, v21, v30
    v_fmac_f32 v11, v21, v31
    v_fmac_f32 v12, v21, v32
    v_fmac_f32 v13, v21, v33
    v_fmac_f32 v14, v21, v34
    v_fmac_f32 v15, v21, v35
    v_lshlrev_b32 v28, 16, v76
    v_and_b32 v29, 0xffff0000, v76
    v_lshlrev_b32 v30, 16, v77
    v_and_b32 v31, 0xffff0000, v77
    v_lshlrev_b32 v32, 16, v78
    v_and_b32 v33, 0xffff0000, v78
    v_lshlrev_b32 v34, 16, v79
    v_and_b32 v35, 0xffff0000, v79
    v_fmac_f32 v8, v22, v28
    v_fmac_f32 v9, v22, v29
    v_fmac_f32 v10, v22, v30
    v_fmac_f32 v11, v22, v31
    v_fmac_f32 v12, v22, v32
    v_fmac_f32 v13, v22, v33
    v_fmac_f32 v14, v22, v34
    v_fmac_f32 v15, v22, v35
    v_lshlrev_b32 v28, 16, v80
    v_and_b32 v29, 0xffff0000, v80
    v_lshlrev_b32 v30, 16, v81
    v_and_b32 v31, 0xffff0000, v81
    v_lshlrev_b32 v32, 16, v82
    v_and_b32 v33, 0xffff0000, v82
    v_lshlrev_b32 v34, 16, v83
    v_and_b32 v35, 0xffff0000, v83
    v_fmac_f32 v8, v23, v28
    v_fmac_f32 v9, v23, v29
    v_fmac_f32 v10, v23, v30
    v_fmac_f32 v11, v23, v31
    v_fmac_f32 v12, v23, v32
    v_fmac_f32 v13, v23, v33
    v_fmac_f32 v14, v23, v34
    v_fmac_f32 v15, v23, v35
    buffer_load_dwordx4 v[68:71], v1, s[24:27], s66 offen nt
    buffer_load_dwordx4 v[72:75], v1, s[24:27], s67 offen nt
    buffer_load_dwordx4 v[76:79], v1, s[24:27], s68 offen nt
    buffer_load_dwordx4 v[80:83], v1, s[24:27], s69 offen nt
    s_add_u32 s63, s63, 8
    s_add_u32 s64, s64, 8

    s_waitcnt vmcnt(12)
    v_dot2_f32_bf16 v20, v52, v4, 0
    v_dot2_f32_bf16 v21, v56, v4, 0
    v_dot2_f32_bf16 v22, v60, v4, 0
    v_dot2_f32_bf16 v23, v64, v4, 0
    v_dot2_f32_bf16 v20, v53, v5, v20
    v_dot2_f32_bf16 v21, v57, v5, v21
    v_dot2_f32_bf16 v22, v61, v5, v22
    v_dot2_f32_bf16 v23, v65, v5, v23
    v_dot2_f32_bf16 v20, v54, v6, v20
    v_dot2_f32_bf16 v21, v58, v6, v21
    v_dot2_f32_bf16 v22, v62, v6, v22
    v_dot2_f32_bf16 v23, v66, v6, v23
    v_dot2_f32_bf16 v20, v55, v7, v20
    v_dot2_f32_bf16 v21, v59, v7, v21
    v_dot2_f32_bf16 v22, v63, v7, v22
    v_dot2_f32_bf16 v23, v67, v7, v23
    s_lshr_b32 s82, s63, 2
    s_sub_u32 s82, s82, s59
    s_and_b32 s82, s82, 63
    v_readlane_b32 s83, v2, s82
    s_and_b32 s84, s63, 3
    s_lshl_b32 s84, s84, 15
    s_add_u32 s84, s84, s65
    s_lshl_b32 s83, s83, 17
    s_add_u32 s83, s83, s84
    s_cmp_lt_u32 s63, s55
    s_cselect_b32 s74, s83, 0x8080000
    s_cselect_b32 s84, 8192, 0

    s_add_u32 s75, s74, s84
    s_add_u32 s76, s75, s84
    s_add_u32 s77, s76, s84
    buffer_load_dwordx4 v[52:55], v1, s[20:23], s74 offen nt
    buffer_load_dwordx4 v[56:59], v1, s[20:23], s75 offen nt
    buffer_load_dwordx4 v[60:63], v1, s[20:23], s76 offen nt
    buffer_load_dwordx4 v[64:67], v1, s[20:23], s77 offen nt
    v_add_f32_dpp v20, v20, v20 row_ror:8 row_mask:0xf bank_mask:0xf
    v_add_f32_dpp v21, v21, v21 row_ror:8 row_mask:0xf bank_mask:0xf
    v_add_f32_dpp v22, v22, v22 row_ror:8 row_mask:0xf bank_mask:0xf
    v_add_f32_dpp v23, v23, v23 row_ror:8 row_mask:0xf bank_mask:0xf
    v_add_f32_dpp v20, v20, v20 row_ror:4 row_mask:0xf bank_mask:0xf
    v_add_f32_dpp v21, v21, v21 row_ror:4 row_mask:0xf bank_mask:0xf
    v_add_f32_dpp v22, v22, v22 row_ror:4 row_mask:0xf bank_mask:0xf
    v_add_f32_dpp v23, v23, v23 row_ror:4 row_mask:0xf bank_mask:0xf
    v_add_f32_dpp v20, v20, v20 row_ror:2 row_mask:0xf bank_mask:0xf
    v_add_f32_dpp v21, v21, v21 row_ror:2 row_mask:0xf bank_mask:0xf
    v_add_f32_dpp v22, v22, v22 row_ror:2 row_mask:0xf bank_mask:0xf
    v_add_f32_dpp v23, v23, v23 row_ror:2 row_mask:0xf bank_mask:0xf
    v_add_f32_dpp v20, v20, v20 row_ror:1 row_mask:0xf bank_mask:0xf
    v_add_f32_dpp v21, v21, v21 row_ror:1 row_mask:0xf bank_mask:0xf
    v_add_f32_dpp v22, v22, v22 row_ror:1 row_mask:0xf bank_mask:0xf
    v_add_f32_dpp v23, v23, v23 row_ror:1 row_mask:0xf bank_mask:0xf
    s_lshl_b32 s82, s64, 2
    s_sub_i32 s82, s61, s82

    s_cmp_gt_i32 s82, 3
    s_cbranch_scc1 L_nomask_2
    v_mov_b32 v23, 0xff800000

    s_cmp_gt_i32 s82, 2
    s_cbranch_scc1 L_nomask_2
    v_mov_b32 v22, 0xff800000

    s_cmp_gt_i32 s82, 1
    s_cbranch_scc1 L_nomask_2
    v_mov_b32 v21, 0xff800000

    s_cmp_gt_i32 s82, 0
    s_cbranch_scc1 L_nomask_2
    v_mov_b32 v20, 0xff800000

L_nomask_2:
    v_max3_f32 v18, v20, v21, v16
    v_max3_f32 v18, v22, v23, v18
    v_mul_f32 v3, s60, v18
    v_fma_f32 v19, v16, s60, -v3

    v_fma_f32 v20, v20, s60, -v3
    v_fma_f32 v21, v21, s60, -v3
    v_fma_f32 v22, v22, s60, -v3
    v_fma_f32 v23, v23, s60, -v3
    v_exp_f32 v19, v19
    v_exp_f32 v20, v20
    v_exp_f32 v21, v21
    v_exp_f32 v22, v22
    v_exp_f32 v23, v23
    v_mov_b32 v16, v18
    v_mul_f32 v8, v19, v8
    v_mul_f32 v9, v19, v9
    v_mul_f32 v10, v19, v10
    v_mul_f32 v11, v19, v11
    v_mul_f32 v12, v19, v12
    v_mul_f32 v13, v19, v13
    v_mul_f32 v14, v19, v14
    v_mul_f32 v15, v19, v15
    v_mul_f32 v17, v19, v17
    v_add_f32 v17, v17, v20
    v_add_f32 v17, v17, v21
    v_add_f32 v17, v17, v22
    v_add_f32 v17, v17, v23
    s_waitcnt vmcnt(12)
    v_lshlrev_b32 v28, 16, v84
    v_and_b32 v29, 0xffff0000, v84
    v_lshlrev_b32 v30, 16, v85
    v_and_b32 v31, 0xffff0000, v85
    v_lshlrev_b32 v32, 16, v86
    v_and_b32 v33, 0xffff0000, v86
    v_lshlrev_b32 v34, 16, v87
    v_and_b32 v35, 0xffff0000, v87
    v_fmac_f32 v8, v20, v28
    v_fmac_f32 v9, v20, v29
    v_fmac_f32 v10, v20, v30
    v_fmac_f32 v11, v20, v31
    v_fmac_f32 v12, v20, v32
    v_fmac_f32 v13, v20, v33
    v_fmac_f32 v14, v20, v34
    v_fmac_f32 v15, v20, v35
    v_lshlrev_b32 v28, 16, v88
    v_and_b32 v29, 0xffff0000, v88
    v_lshlrev_b32 v30, 16, v89
    v_and_b32 v31, 0xffff0000, v89
    v_lshlrev_b32 v32, 16, v90
    v_and_b32 v33, 0xffff0000, v90
    v_lshlrev_b32 v34, 16, v91
    v_and_b32 v35, 0xffff0000, v91
    v_fmac_f32 v8, v21, v28
    v_fmac_f32 v9, v21, v29
    v_fmac_f32 v10, v21, v30
    v_fmac_f32 v11, v21, v31
    v_fmac_f32 v12, v21, v32
    v_fmac_f32 v13, v21, v33
    v_fmac_f32 v14, v21, v34
    v_fmac_f32 v15, v21, v35
    v_lshlrev_b32 v28, 16, v92
    v_and_b32 v29, 0xffff0000, v92
    v_lshlrev_b32 v30, 16, v93
    v_and_b32 v31, 0xffff0000, v93
    v_lshlrev_b32 v32, 16, v94
    v_and_b32 v33, 0xffff0000, v94
    v_lshlrev_b32 v34, 16, v95
    v_and_b32 v35, 0xffff0000, v95
    v_fmac_f32 v8, v22, v28
    v_fmac_f32 v9, v22, v29
    v_fmac_f32 v10, v22, v30
    v_fmac_f32 v11, v22, v31
    v_fmac_f32 v12, v22, v32
    v_fmac_f32 v13, v22, v33
    v_fmac_f32 v14, v22, v34
    v_fmac_f32 v15, v22, v35
    v_lshlrev_b32 v28, 16, v96
    v_and_b32 v29, 0xffff0000, v96
    v_lshlrev_b32 v30, 16, v97
    v_and_b32 v31, 0xffff0000, v97
    v_lshlrev_b32 v32, 16, v98
    v_and_b32 v33, 0xffff0000, v98
    v_lshlrev_b32 v34, 16, v99
    v_and_b32 v35, 0xffff0000, v99
    v_fmac_f32 v8, v23, v28
    v_fmac_f32 v9, v23, v29
    v_fmac_f32 v10, v23, v30
    v_fmac_f32 v11, v23, v31
    v_fmac_f32 v12, v23, v32
    v_fmac_f32 v13, v23, v33
    v_fmac_f32 v14, v23, v34
    v_fmac_f32 v15, v23, v35
    buffer_load_dwordx4 v[84:87], v1, s[24:27], s74 offen nt
    buffer_load_dwordx4 v[88:91], v1, s[24:27], s75 offen nt
    buffer_load_dwordx4 v[92:95], v1, s[24:27], s76 offen nt
    buffer_load_dwordx4 v[96:99], v1, s[24:27], s77 offen nt
    s_add_u32 s63, s63, 8
    s_add_u32 s64, s64, 8

    s_sub_u32 s62, s62, 1
    s_cmp_lg_u32 s62, 0
    s_cbranch_scc1 L_loop

L_loop_done:
    s_waitcnt vmcnt(0)
    v_lshlrev_b32 v3, 1, v1
    s_lshl_b32 s82, s56, 11
    v_add_u32 v3, s82, v3
    ds_write_b128 v3, v[8:11]
    ds_write_b128 v3, v[12:15] offset:16
    v_lshrrev_b32 v3, 8, v1
    v_lshlrev_b32 v3, 3, v3
    s_lshl_b32 s82, s56, 5
    s_add_u32 s82, s82, 32768
    v_add_u32 v3, s82, v3
    ds_write_b64 v3, v[16:17]
    s_waitcnt lgkmcnt(0)
    s_barrier

    v_lshlrev_b32 v3, 2, v0
    v_lshrrev_b32 v4, 9, v3
    v_lshlrev_b32 v5, 3, v4
    v_add_u32 v5, 32768, v5

    ds_read_b64 v[20:21], v5 offset:0
    ds_read_b64 v[22:23], v5 offset:64
    ds_read_b64 v[24:25], v5 offset:128
    ds_read_b64 v[26:27], v5 offset:192
    ds_read_b64 v[28:29], v5 offset:256
    ds_read_b64 v[30:31], v5 offset:320
    ds_read_b64 v[32:33], v5 offset:384
    ds_read_b64 v[34:35], v5 offset:448
    ds_read_b32 v36, v3 offset:0
    ds_read_b32 v37, v3 offset:4096
    ds_read_b32 v38, v3 offset:8192
    ds_read_b32 v39, v3 offset:12288
    ds_read_b32 v40, v3 offset:16384
    ds_read_b32 v41, v3 offset:20480
    ds_read_b32 v42, v3 offset:24576
    ds_read_b32 v43, v3 offset:28672
    s_waitcnt lgkmcnt(8)
    v_mov_b32 v16, v20
    v_max_f32 v16, v16, v22
    v_max_f32 v16, v16, v24
    v_max_f32 v16, v16, v26
    v_max_f32 v16, v16, v28
    v_max_f32 v16, v16, v30
    v_max_f32 v16, v16, v32
    v_max_f32 v16, v16, v34
    v_mul_f32 v6, s60, v16
    v_fma_f32 v20, v20, s60, -v6
    v_fma_f32 v22, v22, s60, -v6
    v_fma_f32 v24, v24, s60, -v6
    v_fma_f32 v26, v26, s60, -v6
    v_fma_f32 v28, v28, s60, -v6
    v_fma_f32 v30, v30, s60, -v6
    v_fma_f32 v32, v32, s60, -v6
    v_fma_f32 v34, v34, s60, -v6
    v_exp_f32 v20, v20
    v_exp_f32 v22, v22
    v_exp_f32 v24, v24
    v_exp_f32 v26, v26
    v_exp_f32 v28, v28
    v_exp_f32 v30, v30
    v_exp_f32 v32, v32
    v_exp_f32 v34, v34
    s_nop 0
    v_mul_f32 v17, v20, v21
    v_fmac_f32 v17, v22, v23
    v_fmac_f32 v17, v24, v25
    v_fmac_f32 v17, v26, v27
    v_fmac_f32 v17, v28, v29
    v_fmac_f32 v17, v30, v31
    v_fmac_f32 v17, v32, v33
    v_fmac_f32 v17, v34, v35
    s_waitcnt lgkmcnt(0)
    v_mul_f32 v8, v20, v36
    v_fmac_f32 v8, v22, v37
    v_fmac_f32 v8, v24, v38
    v_fmac_f32 v8, v26, v39
    v_fmac_f32 v8, v28, v40
    v_fmac_f32 v8, v30, v41
    v_fmac_f32 v8, v32, v42
    v_fmac_f32 v8, v34, v43
    s_lshl_b32 s82, s47, 14
    s_lshl_b32 s83, s48, 12
    s_add_u32 s82, s82, s83

    buffer_store_dword v8, v3, s[36:39], s82 offen sc1
    v_and_b32 v5, 511, v3
    v_cmp_eq_u32 vcc, 0, v5
    s_lshl_b32 s83, s48, 3
    v_add_u32 v4, s83, v4
    v_mul_u32_u24 v4, 512, v4
    s_lshl_b32 s82, s47, 3
    s_add_u32 s82, s82, 0x800000

    s_mul_i32 s83, s49, 16384
    s_sub_u32 s86, 16384, s83
    s_add_u32 s86, s86, s82
    s_add_u32 s82, s82, s83
    v_mov_b32 v18, 0xf1800000
    v_mov_b32 v19, 0

    s_and_saveexec_b64 s[84:85], vcc
    s_cbranch_execz L_main_end
    buffer_store_dwordx2 v[16:17], v4, s[36:39], s82 offen sc1

    buffer_store_dwordx2 v[18:19], v4, s[36:39], s86 offen sc1
L_main_end:
    s_endpgm
.p2align 8
pa_merge_kernel:
    s_cmp_ge_u32 s2, 64
    s_cbranch_scc1 L_mrg_end
    s_load_dwordx2 s[14:15], s[0:1], 40
    s_load_dwordx2 s[18:19], s[0:1], 56
    v_lshrrev_b32 v2, 5, v0
    v_and_b32 v1, 31, v0
    v_lshlrev_b32 v3, 14, v2
    v_lshl_add_u32 v3, v1, 4, v3
    v_lshlrev_b32 v4, 3, v2
    s_mov_b32 s38, 0x1000000
    s_mov_b32 s39, 0x00020000
    s_mov_b32 s30, 16384
    s_mov_b32 s31, 0x00020000
    s_mov_b32 s60, 0x3e0293ee
    s_and_b32 s58, s2, 31
    s_lshl_b32 s82, s58, 9
    s_mul_i32 s83, s2, 512
    s_add_u32 s83, s83, 0x800000
    s_waitcnt lgkmcnt(0)
    s_mov_b32 s36, s18
    s_and_b32 s37, s19, 0xffff
    s_mov_b32 s28, s14
    s_and_b32 s29, s15, 0xffff

    buffer_load_dwordx2 v[8:9], v4, s[36:39], s83 offen offset:0
    buffer_load_dwordx2 v[10:11], v4, s[36:39], s83 offen offset:128
    buffer_load_dwordx2 v[12:13], v4, s[36:39], s83 offen offset:256
    buffer_load_dwordx2 v[14:15], v4, s[36:39], s83 offen offset:384
    buffer_load_dwordx4 v[16:19], v3, s[36:39], s82 offen
    s_add_u32 s82, s82, 262144

    buffer_load_dwordx4 v[20:23], v3, s[36:39], s82 offen
    s_add_u32 s82, s82, 262144

    buffer_load_dwordx4 v[24:27], v3, s[36:39], s82 offen
    s_add_u32 s82, s82, 262144

    buffer_load_dwordx4 v[28:31], v3, s[36:39], s82 offen
    s_add_u32 s82, s82, 262144

    s_waitcnt vmcnt(4)
    v_mov_b32 v36, v8
    v_max_f32 v36, v36, v10
    v_max_f32 v36, v36, v12
    v_max_f32 v36, v36, v14
    v_mul_f32 v6, s60, v36
    v_fma_f32 v8, v8, s60, -v6
    v_fma_f32 v10, v10, s60, -v6
    v_fma_f32 v12, v12, s60, -v6
    v_fma_f32 v14, v14, s60, -v6
    v_exp_f32 v8, v8
    v_exp_f32 v10, v10
    v_exp_f32 v12, v12
    v_exp_f32 v14, v14
    s_nop 0
    v_mul_f32 v37, v8, v9
    s_waitcnt vmcnt(0)
    v_mul_f32 v32, v8, v16
    v_mul_f32 v33, v8, v17
    v_mul_f32 v34, v8, v18
    v_mul_f32 v35, v8, v19
    v_fmac_f32 v37, v10, v11
    v_fmac_f32 v32, v10, v20
    v_fmac_f32 v33, v10, v21
    v_fmac_f32 v34, v10, v22
    v_fmac_f32 v35, v10, v23
    v_fmac_f32 v37, v12, v13
    v_fmac_f32 v32, v12, v24
    v_fmac_f32 v33, v12, v25
    v_fmac_f32 v34, v12, v26
    v_fmac_f32 v35, v12, v27
    v_fmac_f32 v37, v14, v15
    v_fmac_f32 v32, v14, v28
    v_fmac_f32 v33, v14, v29
    v_fmac_f32 v34, v14, v30
    v_fmac_f32 v35, v14, v31
    v_lshlrev_b32 v3, 4, v0
    ds_write_b128 v3, v[32:35]
    v_lshlrev_b32 v4, 3, v2
    ds_write_b64 v4, v[36:37] offset:8192
    s_waitcnt lgkmcnt(0)
    s_barrier
    v_cmp_gt_u32 vcc, 32, v0
    s_and_saveexec_b64 s[84:85], vcc
    s_cbranch_execz L_mrg_end
    v_mov_b32 v4, 0

    ds_read_b64 v[8:9], v4 offset:8192
    ds_read_b64 v[10:11], v4 offset:8200
    ds_read_b64 v[12:13], v4 offset:8208
    ds_read_b64 v[14:15], v4 offset:8216
    ds_read_b64 v[16:17], v4 offset:8224
    ds_read_b64 v[18:19], v4 offset:8232
    ds_read_b64 v[20:21], v4 offset:8240
    ds_read_b64 v[22:23], v4 offset:8248
    ds_read_b64 v[24:25], v4 offset:8256
    ds_read_b64 v[26:27], v4 offset:8264
    ds_read_b64 v[28:29], v4 offset:8272
    ds_read_b64 v[30:31], v4 offset:8280
    ds_read_b64 v[32:33], v4 offset:8288
    ds_read_b64 v[34:35], v4 offset:8296
    ds_read_b64 v[36:37], v4 offset:8304
    ds_read_b64 v[38:39], v4 offset:8312
    ds_read_b128 v[40:43], v3 offset:0
    ds_read_b128 v[44:47], v3 offset:512
    ds_read_b128 v[48:51], v3 offset:1024
    ds_read_b128 v[52:55], v3 offset:1536
    ds_read_b128 v[56:59], v3 offset:2048
    ds_read_b128 v[60:63], v3 offset:2560
    ds_read_b128 v[64:67], v3 offset:3072
    ds_read_b128 v[68:71], v3 offset:3584
    ds_read_b128 v[72:75], v3 offset:4096
    ds_read_b128 v[76:79], v3 offset:4608
    ds_read_b128 v[80:83], v3 offset:5120
    ds_read_b128 v[84:87], v3 offset:5632
    ds_read_b128 v[88:91], v3 offset:6144
    ds_read_b128 v[92:95], v3 offset:6656
    ds_read_b128 v[96:99], v3 offset:7168
    ds_read_b128 v[100:103], v3 offset:7680
    s_waitcnt lgkmcnt(0)
    v_mov_b32 v5, v8
    v_max_f32 v5, v5, v10
    v_max_f32 v5, v5, v12
    v_max_f32 v5, v5, v14
    v_max_f32 v5, v5, v16
    v_max_f32 v5, v5, v18
    v_max_f32 v5, v5, v20
    v_max_f32 v5, v5, v22
    v_max_f32 v5, v5, v24
    v_max_f32 v5, v5, v26
    v_max_f32 v5, v5, v28
    v_max_f32 v5, v5, v30
    v_max_f32 v5, v5, v32
    v_max_f32 v5, v5, v34
    v_max_f32 v5, v5, v36
    v_max_f32 v5, v5, v38
    v_mul_f32 v6, s60, v5
    v_fma_f32 v8, v8, s60, -v6
    v_fma_f32 v10, v10, s60, -v6
    v_fma_f32 v12, v12, s60, -v6
    v_fma_f32 v14, v14, s60, -v6
    v_fma_f32 v16, v16, s60, -v6
    v_fma_f32 v18, v18, s60, -v6
    v_fma_f32 v20, v20, s60, -v6
    v_fma_f32 v22, v22, s60, -v6
    v_fma_f32 v24, v24, s60, -v6
    v_fma_f32 v26, v26, s60, -v6
    v_fma_f32 v28, v28, s60, -v6
    v_fma_f32 v30, v30, s60, -v6
    v_fma_f32 v32, v32, s60, -v6
    v_fma_f32 v34, v34, s60, -v6
    v_fma_f32 v36, v36, s60, -v6
    v_fma_f32 v38, v38, s60, -v6
    v_exp_f32 v8, v8
    v_exp_f32 v10, v10
    v_exp_f32 v12, v12
    v_exp_f32 v14, v14
    v_exp_f32 v16, v16
    v_exp_f32 v18, v18
    v_exp_f32 v20, v20
    v_exp_f32 v22, v22
    v_exp_f32 v24, v24
    v_exp_f32 v26, v26
    v_exp_f32 v28, v28
    v_exp_f32 v30, v30
    v_exp_f32 v32, v32
    v_exp_f32 v34, v34
    v_exp_f32 v36, v36
    v_exp_f32 v38, v38
    s_nop 0
    v_mul_f32 v7, v8, v9
    v_mul_f32 v40, v8, v40
    v_mul_f32 v41, v8, v41
    v_mul_f32 v42, v8, v42
    v_mul_f32 v43, v8, v43
    v_fmac_f32 v7, v10, v11
    v_fmac_f32 v40, v10, v44
    v_fmac_f32 v41, v10, v45
    v_fmac_f32 v42, v10, v46
    v_fmac_f32 v43, v10, v47
    v_fmac_f32 v7, v12, v13
    v_fmac_f32 v40, v12, v48
    v_fmac_f32 v41, v12, v49
    v_fmac_f32 v42, v12, v50
    v_fmac_f32 v43, v12, v51
    v_fmac_f32 v7, v14, v15
    v_fmac_f32 v40, v14, v52
    v_fmac_f32 v41, v14, v53
    v_fmac_f32 v42, v14, v54
    v_fmac_f32 v43, v14, v55
    v_fmac_f32 v7, v16, v17
    v_fmac_f32 v40, v16, v56
    v_fmac_f32 v41, v16, v57
    v_fmac_f32 v42, v16, v58
    v_fmac_f32 v43, v16, v59
    v_fmac_f32 v7, v18, v19
    v_fmac_f32 v40, v18, v60
    v_fmac_f32 v41, v18, v61
    v_fmac_f32 v42, v18, v62
    v_fmac_f32 v43, v18, v63
    v_fmac_f32 v7, v20, v21
    v_fmac_f32 v40, v20, v64
    v_fmac_f32 v41, v20, v65
    v_fmac_f32 v42, v20, v66
    v_fmac_f32 v43, v20, v67
    v_fmac_f32 v7, v22, v23
    v_fmac_f32 v40, v22, v68
    v_fmac_f32 v41, v22, v69
    v_fmac_f32 v42, v22, v70
    v_fmac_f32 v43, v22, v71
    v_fmac_f32 v7, v24, v25
    v_fmac_f32 v40, v24, v72
    v_fmac_f32 v41, v24, v73
    v_fmac_f32 v42, v24, v74
    v_fmac_f32 v43, v24, v75
    v_fmac_f32 v7, v26, v27
    v_fmac_f32 v40, v26, v76
    v_fmac_f32 v41, v26, v77
    v_fmac_f32 v42, v26, v78
    v_fmac_f32 v43, v26, v79
    v_fmac_f32 v7, v28, v29
    v_fmac_f32 v40, v28, v80
    v_fmac_f32 v41, v28, v81
    v_fmac_f32 v42, v28, v82
    v_fmac_f32 v43, v28, v83
    v_fmac_f32 v7, v30, v31
    v_fmac_f32 v40, v30, v84
    v_fmac_f32 v41, v30, v85
    v_fmac_f32 v42, v30, v86
    v_fmac_f32 v43, v30, v87
    v_fmac_f32 v7, v32, v33
    v_fmac_f32 v40, v32, v88
    v_fmac_f32 v41, v32, v89
    v_fmac_f32 v42, v32, v90
    v_fmac_f32 v43, v32, v91
    v_fmac_f32 v7, v34, v35
    v_fmac_f32 v40, v34, v92
    v_fmac_f32 v41, v34, v93
    v_fmac_f32 v42, v34, v94
    v_fmac_f32 v43, v34, v95
    v_fmac_f32 v7, v36, v37
    v_fmac_f32 v40, v36, v96
    v_fmac_f32 v41, v36, v97
    v_fmac_f32 v42, v36, v98
    v_fmac_f32 v43, v36, v99
    v_fmac_f32 v7, v38, v39
    v_fmac_f32 v40, v38, v100
    v_fmac_f32 v41, v38, v101
    v_fmac_f32 v42, v38, v102
    v_fmac_f32 v43, v38, v103
    v_rcp_f32 v7, v7
    s_nop 0
    v_mul_f32 v40, v40, v7
    v_mul_f32 v41, v41, v7
    v_mul_f32 v42, v42, v7
    v_mul_f32 v43, v43, v7
    v_cvt_pk_bf16_f32 v4, v40, v41
    v_cvt_pk_bf16_f32 v5, v42, v43
    v_lshlrev_b32 v3, 3, v0
    s_lshl_b32 s82, s2, 8
    buffer_store_dwordx2 v[4:5], v3, s[28:31], s82 offen

L_mrg_end:
    s_endpgm
.section .rodata,"a"
.p2align 6
.amdhsa_kernel pa_main_kernel
  .amdhsa_next_free_vgpr 100
  .amdhsa_next_free_sgpr 96
  .amdhsa_accum_offset 100
  .amdhsa_group_segment_fixed_size 0
  .amdhsa_kernarg_size 64
  .amdhsa_user_sgpr_count 2
  .amdhsa_user_sgpr_kernarg_segment_ptr 1
  .amdhsa_system_sgpr_workgroup_id_x 1
.end_amdhsa_kernel
.p2align 6
.amdhsa_kernel pa_merge_kernel
  .amdhsa_next_free_vgpr 104
  .amdhsa_next_free_sgpr 96
  .amdhsa_accum_offset 104
  .amdhsa_group_segment_fixed_size 0
  .amdhsa_kernarg_size 64
  .amdhsa_user_sgpr_count 2
  .amdhsa_user_sgpr_kernarg_segment_ptr 1
  .amdhsa_system_sgpr_workgroup_id_x 1
.end_amdhsa_kernel
```
